```python
import torch

def _softmax(x, axis=-1):
    return torch.softmax(x, dim=axis)
def _gelu(x):
    return torch.nn.functional.gelu(x, approximate="tanh")
def _silu(x):
    return torch.nn.functional.silu(x)
def _sigmoid(x):
    return torch.sigmoid(x)
def _layernorm(x, axis=-1, eps=1e-5):
    m = x.mean(dim=axis, keepdim=True)
    v = x.var(dim=axis, keepdim=True, unbiased=False)
    return (x - m) / torch.sqrt(v + eps)
def _scatter_add(tgt, idx, src, axis=0):
    return tgt.clone().index_add_(axis, idx, src)
def _segment_sum(src, seg, n):
    out = torch.zeros((n,) + src.shape[1:], dtype=src.dtype)
    return out.index_add_(0, seg, src)
def _pad(x, pw):
    flat = tuple(v for pair in reversed(pw) for v in pair)
    return torch.nn.functional.pad(x, flat)

kernel_name = 'standalone__softmax_full_bidir__decode'

def setup_inputs():

    _w = (lambda a: (lambda t: t.to(torch.bfloat16) if t.is_floating_point() else t)(torch.as_tensor(a)))
    B, H, Sq, Skv, Dh = 4, 32, 1, 4096, 192
    return {
        "q": _w((lambda *s: torch.randn(*s, dtype=torch.bfloat16) * 0.8)(B, H, Sq, Dh)),
        "k": _w((lambda *s: torch.randn(*s, dtype=torch.bfloat16) * 0.8)(B, H, Skv, Dh)),
        "v": _w((lambda *s: torch.randn(*s, dtype=torch.bfloat16) * 0.05)(B, H, Skv, Dh)),
    }

def reference(q, k, v):
    scale = q.shape[-1] ** -0.5
    scores = torch.einsum('bhqd,bhkd->bhqk', q, k) * scale
    attn = _softmax(scores, axis=-1)
    return torch.einsum('bhqk,bhkd->bhqd', attn, v)
```

```asm
; @launch grid=(256,1,1) block=(512,1,1) lds=18432
.amdgcn_target "amdgcn-amd-amdhsa--gfx950"
.text
.globl standalone__softmax_full_bidir__decode_kernel
.p2align 8
.type standalone__softmax_full_bidir__decode_kernel,@function
standalone__softmax_full_bidir__decode_kernel:
  s_cmpk_ge_u32 s2, 256
  s_cbranch_scc1 L_end
  s_load_dwordx8 s[4:11], s[0:1], 0
  s_load_dwordx4 s[12:15], s[0:1], 32
  v_lshrrev_b32 v8, 6, v0
  v_and_b32 v0, 63, v0
  v_readfirstlane_b32 s31, v8
  s_getpc_b64 s[48:49]
  v_lshlrev_b32 v9, 6, v0
  s_cmp_lt_u32 s31, 2
  s_cbranch_scc1 L_stream
  global_load_dword v10, v9, s[48:49]
  s_cmp_eq_u32 s31, 2
  s_cbranch_scc1 L_service
  s_mov_b64 exec, 0
  s_cmp_eq_u32 s31, 3
  s_cbranch_scc1 PAD0
  s_cmp_eq_u32 s31, 4
  s_cbranch_scc1 PAD1
  s_cmp_eq_u32 s31, 5
  s_cbranch_scc1 PAD2
  s_cmp_eq_u32 s31, 6
  s_cbranch_scc1 PAD3
  s_branch PAD4
L_stream:
  s_lshr_b32 s39, s2, 3
  s_and_b32 s37, s2, 7
  s_lshl_b32 s36, s39, 2
  v_and_b32 v8, 15, v0
  v_lshrrev_b32 v9, 4, v0
  v_lshrrev_b32 v10, 2, v8
  v_mul_u32_u24 v10, 1536, v10
  v_and_b32 v11, 3, v0
  v_lshl_add_u32 v10, v11, 4, v10
  v_lshl_add_u32 v1, v9, 6, v10
  v_lshrrev_b32 v2, 1, v9
  v_mul_u32_u24 v2, 384, v2
  v_add_u32 v2, v2, v10
  v_and_b32 v10, 1, v9
  v_lshl_add_u32 v2, v10, 6, v2
  v_add_u32 v2, 256, v2
  s_lshr_b32 s28, s37, 2
  s_lshl_b32 s28, s28, 3
  s_and_b32 s34, s37, 3
  s_add_u32 s28, s28, s34
  s_lshl2_add_u32 s28, s31, s28
  s_lshl_b32 s34, s36, 8
  s_add_u32 s28, s28, s34
  s_mul_i32 s28, s28, 6144
  s_mov_b32 s60, 201326592
  s_mov_b32 s18, s60
  s_mov_b32 s19, 0x20000
  s_waitcnt lgkmcnt(0)
  s_mov_b32 s16, s6
  s_and_b32 s17, s7, 0xffff
  buffer_load_dwordx4 v[72:75], v1, s[16:19], s28 offen offset:0 nt
  buffer_load_dwordx4 v[76:79], v1, s[16:19], s28 offen offset:384 nt
  buffer_load_dwordx4 v[80:83], v1, s[16:19], s28 offen offset:768 nt
  buffer_load_dwordx4 v[84:87], v1, s[16:19], s28 offen offset:1152 nt
  buffer_load_dwordx4 v[88:91], v2, s[16:19], s28 offen offset:0 nt
  buffer_load_dwordx4 v[92:95], v2, s[16:19], s28 offen offset:768 nt
  s_mov_b32 s30, 0x3dd53b95
PAD0:
  s_cbranch_execz PAD5
  v_and_b32 v11, 3, v0
  v_lshlrev_b32 v10, 4, v11
  v_lshl_add_u32 v36, v9, 6, v10
  v_and_b32 v38, 1, v9
  v_lshl_add_u32 v38, v38, 6, v10
  v_add_u32 v38, 256, v38
  v_mov_b32 v10, 0x40000000
  v_cmp_gt_u32 vcc, 32, v0
  s_nop 1
  v_cndmask_b32 v37, v10, v38, vcc
  v_cndmask_b32 v38, v38, v10, vcc
PAD1:
  s_cbranch_execz PAD6
  s_mul_i32 s34, s36, 384
  s_add_u32 s24, s4, s34
  s_addc_u32 s25, s5, 0
  s_and_b32 s25, s25, 0xffff
  s_mov_b32 s26, 1536
  s_mov_b32 s27, 0x20000
  buffer_load_dwordx4 v[16:19], v36, s[24:27], 0 offen
  buffer_load_dwordx4 v[20:23], v37, s[24:27], 0 offen
  buffer_load_dwordx4 v[24:27], v38, s[24:27], 0 offen
PAD2:
  s_cbranch_execz PAD7
  v_mul_u32_u24 v10, 1536, v9
  v_lshl_add_u32 v3, v8, 4, v10
  v_lshrrev_b32 v4, 3, v8
  v_mul_u32_u24 v4, 384, v4
  v_add_u32 v4, v4, v10
  v_and_b32 v10, 7, v0
  v_lshl_add_u32 v4, v10, 4, v4
  v_add_u32 v4, 256, v4
  s_mov_b32 s20, s8
PAD3:
  s_cbranch_execz PAD8
  s_and_b32 s21, s9, 0xffff
  s_mov_b32 s22, s60
  s_mov_b32 s23, 0x20000
  buffer_load_dwordx4 v[96:99], v3, s[20:23], s28 offen offset:0 nt
  buffer_load_dwordx4 v[100:103], v3, s[20:23], s28 offen offset:384 nt
  buffer_load_dwordx4 v[104:107], v3, s[20:23], s28 offen offset:768 nt
  buffer_load_dwordx4 v[108:111], v3, s[20:23], s28 offen offset:1152 nt
  buffer_load_dwordx4 v[112:115], v4, s[20:23], s28 offen offset:0 nt
PAD4:
  s_cbranch_execz PAD9
  buffer_load_dwordx4 v[116:119], v4, s[20:23], s28 offen offset:768 nt
  v_mov_b32 v5, 0xff7fffff
  v_mov_b32 v6, 0xff7fffff
  v_mov_b32 v7, 0
  v_mov_b32 v28, 0
  v_mov_b32 v29, 0
  v_mov_b32 v30, 0
  v_mov_b32 v31, 0
  v_mov_b32 v32, 0
  v_mov_b32 v33, 0
  v_mov_b32 v34, 0
  v_mov_b32 v35, 0
PAD5:
  s_cbranch_execz PAD10
  v_and_b32 v10, 1, v0
  v_lshlrev_b32 v10, 4, v10
  v_mov_b32 v11, 0xffff
  v_lshlrev_b32 v10, v10, v11
  v_bfe_u32 v11, v0, 1, 2
  v_cmp_eq_u32 vcc, 0, v11
  s_nop 1
  v_cndmask_b32 v12, 0, v10, vcc
  v_cmp_eq_u32 vcc, 1, v11
  s_nop 1
  v_cndmask_b32 v13, 0, v10, vcc
  v_cmp_eq_u32 vcc, 2, v11
  s_nop 1
PAD6:
  s_cbranch_execz PAD11
  v_cndmask_b32 v14, 0, v10, vcc
  v_cmp_eq_u32 vcc, 3, v11
  s_nop 1
  v_cndmask_b32 v15, 0, v10, vcc
  v_cmp_gt_u32 s[32:33], 8, v8
  s_mov_b32 s29, 0
  s_mov_b32 s56, 0
  s_mov_b32 s64, 1
  s_mov_b32 s65, 1
  s_mov_b64 s[52:53], s[14:15]
L_loop:
  s_cmp_eq_u32 s64, 0
  s_cbranch_scc1 L_final
  s_waitcnt vmcnt(6)
  s_cmpk_lt_u32 s29, 59
PAD7:
  s_cbranch_execz PAD12
  s_cbranch_scc0 L_dyn_m0
  s_add_u32 s28, s28, 98304
L_issue_m0:
  buffer_load_dwordx4 v[120:123], v1, s[16:19], s28 offen offset:0 nt
  buffer_load_dwordx4 v[124:127], v1, s[16:19], s28 offen offset:384 nt
  buffer_load_dwordx4 v[128:131], v1, s[16:19], s28 offen offset:768 nt
  buffer_load_dwordx4 v[132:135], v1, s[16:19], s28 offen offset:1152 nt
  buffer_load_dwordx4 v[136:139], v2, s[16:19], s28 offen offset:0 nt
  buffer_load_dwordx4 v[140:143], v2, s[16:19], s28 offen offset:768 nt
PAD8:
  s_cbranch_execz PAD13
  s_cmpk_ge_u32 s29, 58
  s_cbranch_scc1 L_claim_m0
L_claimed_m0:
  v_mfma_f32_16x16x32_bf16 v[36:39], v[72:75], v[16:19], 0
  v_mfma_f32_16x16x32_bf16 v[40:43], v[76:79], v[16:19], 0
  v_mfma_f32_16x16x32_bf16 v[44:47], v[80:83], v[16:19], 0
  v_mfma_f32_16x16x32_bf16 v[48:51], v[84:87], v[16:19], 0
  v_mfma_f32_16x16x32_bf16 v[36:39], v[88:91], v[20:23], v[36:39]
  v_mfma_f32_16x16x32_bf16 v[40:43], v[88:91], v[24:27], v[40:43]
  v_mfma_f32_16x16x32_bf16 v[44:47], v[92:95], v[20:23], v[44:47]
PAD9:
  s_cbranch_execz PAD14
  v_mfma_f32_16x16x32_bf16 v[48:51], v[92:95], v[24:27], v[48:51]
  s_nop 7
  v_mov_b32_dpp v52, v36 quad_perm:[0,0,0,0] row_mask:0xf bank_mask:0xf
  v_mov_b32_dpp v53, v40 quad_perm:[0,0,0,0] row_mask:0xf bank_mask:0xf
  v_mov_b32_dpp v54, v44 quad_perm:[0,0,0,0] row_mask:0xf bank_mask:0xf
  v_mov_b32_dpp v55, v48 quad_perm:[0,0,0,0] row_mask:0xf bank_mask:0xf
  v_add_f32_dpp v52, v37, v52 quad_perm:[1,1,1,1] row_mask:0xf bank_mask:0xf
  v_add_f32_dpp v53, v41, v53 quad_perm:[1,1,1,1] row_mask:0xf bank_mask:0xf
PAD10:
  s_cbranch_execz PAD15
  v_add_f32_dpp v54, v45, v54 quad_perm:[1,1,1,1] row_mask:0xf bank_mask:0xf
  v_add_f32_dpp v55, v49, v55 quad_perm:[1,1,1,1] row_mask:0xf bank_mask:0xf
  v_add_f32_dpp v52, v38, v52 quad_perm:[2,2,2,2] row_mask:0xf bank_mask:0xf
  v_add_f32_dpp v53, v42, v53 quad_perm:[2,2,2,2] row_mask:0xf bank_mask:0xf
  v_add_f32_dpp v54, v46, v54 quad_perm:[2,2,2,2] row_mask:0xf bank_mask:0xf
  v_add_f32_dpp v55, v50, v55 quad_perm:[2,2,2,2] row_mask:0xf bank_mask:0xf
  v_add_f32_dpp v52, v39, v52 quad_perm:[3,3,3,3] row_mask:0xf bank_mask:0xf
PAD11:
  s_cbranch_execz PAD16
  v_add_f32_dpp v53, v43, v53 quad_perm:[3,3,3,3] row_mask:0xf bank_mask:0xf
  v_add_f32_dpp v54, v47, v54 quad_perm:[3,3,3,3] row_mask:0xf bank_mask:0xf
  v_add_f32_dpp v55, v51, v55 quad_perm:[3,3,3,3] row_mask:0xf bank_mask:0xf
  v_max3_f32 v8, v52, v53, v54
  v_max_f32 v8, v8, v55
  v_cmp_gt_f32 vcc, v8, v5
  s_cbranch_vccz L_keep_m0
  v_mov_b32 v9, v8
  s_nop 1
  v_permlane32_swap_b32 v8, v9
  v_max_f32 v8, v8, v9
PAD12:
  s_cbranch_execz PAD17
  v_mov_b32 v9, v8
  s_nop 1
  v_permlane16_swap_b32 v8, v9
  v_max_f32 v8, v8, v9
  v_max_f32 v5, v5, v8
  v_mul_f32 v9, s30, v5
  v_sub_f32 v8, v6, v9
  v_exp_f32 v8, v8
  v_mov_b32 v6, v9
  v_mul_f32 v28, v8, v28
  v_mul_f32 v29, v8, v29
  v_mul_f32 v30, v8, v30
  v_mul_f32 v31, v8, v31
  v_mul_f32 v32, v8, v32
  v_mul_f32 v33, v8, v33
PAD13:
  s_cbranch_execz PAD18
  v_mul_f32 v34, v8, v34
  v_mul_f32 v35, v8, v35
  v_mul_f32 v7, v8, v7
L_keep_m0:
  v_fma_f32 v52, v52, s30, -v6
  v_fma_f32 v53, v53, s30, -v6
  v_fma_f32 v54, v54, s30, -v6
  v_fma_f32 v55, v55, s30, -v6
  v_exp_f32 v52, v52
  v_exp_f32 v53, v53
  v_exp_f32 v54, v54
  v_exp_f32 v55, v55
PAD14:
  s_cbranch_execz PAD19
  s_nop 0
  v_cvt_pk_bf16_f32 v56, v52, v52
  v_cvt_pk_bf16_f32 v57, v53, v53
  v_cvt_pk_bf16_f32 v58, v54, v54
  v_cvt_pk_bf16_f32 v59, v55, v55
  v_add_f32 v8, v52, v53
  v_add_f32 v9, v54, v55
  v_cndmask_b32 v60, v57, v56, s[32:33]
  v_cndmask_b32 v61, v59, v58, s[32:33]
PAD15:
  s_cbranch_execz PAD20
  v_add_f32 v8, v8, v9
  v_add_f32 v7, v7, v8
  v_and_b32 v64, v56, v12
  v_and_b32 v65, v56, v13
  v_and_b32 v66, v56, v14
  v_and_b32 v67, v56, v15
  s_waitcnt vmcnt(6)
  buffer_load_dwordx4 v[144:147], v3, s[20:23], s28 offen offset:0 nt
  buffer_load_dwordx4 v[148:151], v3, s[20:23], s28 offen offset:384 nt
  buffer_load_dwordx4 v[152:155], v3, s[20:23], s28 offen offset:768 nt
  buffer_load_dwordx4 v[156:159], v3, s[20:23], s28 offen offset:1152 nt
PAD16:
  s_cbranch_execz PAD21
  buffer_load_dwordx4 v[160:163], v4, s[20:23], s28 offen offset:0 nt
  buffer_load_dwordx4 v[164:167], v4, s[20:23], s28 offen offset:768 nt
  v_and_b32 v68, v57, v12
  v_and_b32 v69, v57, v13
  v_and_b32 v70, v57, v14
  v_and_b32 v71, v57, v15
  v_mfma_f32_16x16x32_bf16 v[28:31], v[64:67], v[96:99], v[28:31]
  v_and_b32 v64, v58, v12
  v_and_b32 v65, v58, v13
  v_and_b32 v66, v58, v14
  v_and_b32 v67, v58, v15
  v_mfma_f32_16x16x32_bf16 v[28:31], v[68:71], v[100:103], v[28:31]
PAD17:
  s_cbranch_execz PAD22
  v_and_b32 v68, v59, v12
  v_and_b32 v69, v59, v13
  v_and_b32 v70, v59, v14
  v_and_b32 v71, v59, v15
  v_mfma_f32_16x16x32_bf16 v[28:31], v[64:67], v[104:107], v[28:31]
  v_and_b32 v64, v60, v12
  v_and_b32 v65, v60, v13
  v_and_b32 v66, v60, v14
  v_and_b32 v67, v60, v15
  v_mfma_f32_16x16x32_bf16 v[28:31], v[68:71], v[108:111], v[28:31]
  v_and_b32 v68, v61, v12
  v_and_b32 v69, v61, v13
PAD18:
  s_cbranch_execz PAD23
  v_and_b32 v70, v61, v14
  v_and_b32 v71, v61, v15
  v_mfma_f32_16x16x32_bf16 v[32:35], v[64:67], v[112:115], v[32:35]
  s_nop 1
  v_mfma_f32_16x16x32_bf16 v[32:35], v[68:71], v[116:119], v[32:35]
  s_add_u32 s29, s29, 1
  s_cmp_eq_u32 s65, 0
  s_cbranch_scc1 L_final
  s_waitcnt vmcnt(6)
  s_cmpk_lt_u32 s29, 59
  s_cbranch_scc0 L_dyn_m1
  s_add_u32 s28, s28, 98304
L_issue_m1:
PAD19:
  s_cbranch_execz PAD24
  buffer_load_dwordx4 v[72:75], v1, s[16:19], s28 offen offset:0 nt
  buffer_load_dwordx4 v[76:79], v1, s[16:19], s28 offen offset:384 nt
  buffer_load_dwordx4 v[80:83], v1, s[16:19], s28 offen offset:768 nt
  buffer_load_dwordx4 v[84:87], v1, s[16:19], s28 offen offset:1152 nt
  buffer_load_dwordx4 v[88:91], v2, s[16:19], s28 offen offset:0 nt
  buffer_load_dwordx4 v[92:95], v2, s[16:19], s28 offen offset:768 nt
  s_cmpk_ge_u32 s29, 58
  s_cbranch_scc1 L_claim_m1
L_claimed_m1:
  v_mfma_f32_16x16x32_bf16 v[36:39], v[120:123], v[16:19], 0
PAD20:
  s_cbranch_execz PAD25
  v_mfma_f32_16x16x32_bf16 v[40:43], v[124:127], v[16:19], 0
  v_mfma_f32_16x16x32_bf16 v[44:47], v[128:131], v[16:19], 0
  v_mfma_f32_16x16x32_bf16 v[48:51], v[132:135], v[16:19], 0
  v_mfma_f32_16x16x32_bf16 v[36:39], v[136:139], v[20:23], v[36:39]
  v_mfma_f32_16x16x32_bf16 v[40:43], v[136:139], v[24:27], v[40:43]
  v_mfma_f32_16x16x32_bf16 v[44:47], v[140:143], v[20:23], v[44:47]
  v_mfma_f32_16x16x32_bf16 v[48:51], v[140:143], v[24:27], v[48:51]
PAD21:
  s_cbranch_execz PAD26
  s_nop 7
  v_mov_b32_dpp v52, v36 quad_perm:[0,0,0,0] row_mask:0xf bank_mask:0xf
  v_mov_b32_dpp v53, v40 quad_perm:[0,0,0,0] row_mask:0xf bank_mask:0xf
  v_mov_b32_dpp v54, v44 quad_perm:[0,0,0,0] row_mask:0xf bank_mask:0xf
  v_mov_b32_dpp v55, v48 quad_perm:[0,0,0,0] row_mask:0xf bank_mask:0xf
  v_add_f32_dpp v52, v37, v52 quad_perm:[1,1,1,1] row_mask:0xf bank_mask:0xf
  v_add_f32_dpp v53, v41, v53 quad_perm:[1,1,1,1] row_mask:0xf bank_mask:0xf
  v_add_f32_dpp v54, v45, v54 quad_perm:[1,1,1,1] row_mask:0xf bank_mask:0xf
PAD22:
  s_cbranch_execz PAD27
  v_add_f32_dpp v55, v49, v55 quad_perm:[1,1,1,1] row_mask:0xf bank_mask:0xf
  v_add_f32_dpp v52, v38, v52 quad_perm:[2,2,2,2] row_mask:0xf bank_mask:0xf
  v_add_f32_dpp v53, v42, v53 quad_perm:[2,2,2,2] row_mask:0xf bank_mask:0xf
  v_add_f32_dpp v54, v46, v54 quad_perm:[2,2,2,2] row_mask:0xf bank_mask:0xf
  v_add_f32_dpp v55, v50, v55 quad_perm:[2,2,2,2] row_mask:0xf bank_mask:0xf
  v_add_f32_dpp v52, v39, v52 quad_perm:[3,3,3,3] row_mask:0xf bank_mask:0xf
  v_add_f32_dpp v53, v43, v53 quad_perm:[3,3,3,3] row_mask:0xf bank_mask:0xf
  v_add_f32_dpp v54, v47, v54 quad_perm:[3,3,3,3] row_mask:0xf bank_mask:0xf
PAD23:
  s_cbranch_execz PAD28
  v_add_f32_dpp v55, v51, v55 quad_perm:[3,3,3,3] row_mask:0xf bank_mask:0xf
  v_max3_f32 v8, v52, v53, v54
  v_max_f32 v8, v8, v55
  v_cmp_gt_f32 vcc, v8, v5
  s_cbranch_vccz L_keep_m1
  v_mov_b32 v9, v8
  s_nop 1
  v_permlane32_swap_b32 v8, v9
  v_max_f32 v8, v8, v9
  v_mov_b32 v9, v8
  s_nop 1
  v_permlane16_swap_b32 v8, v9
PAD24:
  s_cbranch_execz PAD29
  v_max_f32 v8, v8, v9
  v_max_f32 v5, v5, v8
  v_mul_f32 v9, s30, v5
  v_sub_f32 v8, v6, v9
  v_exp_f32 v8, v8
  v_mov_b32 v6, v9
  v_mul_f32 v28, v8, v28
  v_mul_f32 v29, v8, v29
  v_mul_f32 v30, v8, v30
  v_mul_f32 v31, v8, v31
  v_mul_f32 v32, v8, v32
  v_mul_f32 v33, v8, v33
  v_mul_f32 v34, v8, v34
  v_mul_f32 v35, v8, v35
  v_mul_f32 v7, v8, v7
L_keep_m1:
PAD25:
  s_cbranch_execz PAD30
  v_fma_f32 v52, v52, s30, -v6
  v_fma_f32 v53, v53, s30, -v6
  v_fma_f32 v54, v54, s30, -v6
  v_fma_f32 v55, v55, s30, -v6
  v_exp_f32 v52, v52
  v_exp_f32 v53, v53
  v_exp_f32 v54, v54
  v_exp_f32 v55, v55
  s_nop 0
  v_cvt_pk_bf16_f32 v56, v52, v52
PAD26:
  s_cbranch_execz PAD31
  v_cvt_pk_bf16_f32 v57, v53, v53
  v_cvt_pk_bf16_f32 v58, v54, v54
  v_cvt_pk_bf16_f32 v59, v55, v55
  v_add_f32 v8, v52, v53
  v_add_f32 v9, v54, v55
  v_cndmask_b32 v60, v57, v56, s[32:33]
  v_cndmask_b32 v61, v59, v58, s[32:33]
  v_add_f32 v8, v8, v9
  v_add_f32 v7, v7, v8
  v_and_b32 v64, v56, v12
PAD27:
  s_cbranch_execz PAD32
  v_and_b32 v65, v56, v13
  v_and_b32 v66, v56, v14
  v_and_b32 v67, v56, v15
  s_waitcnt vmcnt(6)
  buffer_load_dwordx4 v[96:99], v3, s[20:23], s28 offen offset:0 nt
  buffer_load_dwordx4 v[100:103], v3, s[20:23], s28 offen offset:384 nt
  buffer_load_dwordx4 v[104:107], v3, s[20:23], s28 offen offset:768 nt
  buffer_load_dwordx4 v[108:111], v3, s[20:23], s28 offen offset:1152 nt
  buffer_load_dwordx4 v[112:115], v4, s[20:23], s28 offen offset:0 nt
  buffer_load_dwordx4 v[116:119], v4, s[20:23], s28 offen offset:768 nt
PAD28:
  s_cbranch_execz PAD33
  v_and_b32 v68, v57, v12
  v_and_b32 v69, v57, v13
  v_and_b32 v70, v57, v14
  v_and_b32 v71, v57, v15
  v_mfma_f32_16x16x32_bf16 v[28:31], v[64:67], v[144:147], v[28:31]
  v_and_b32 v64, v58, v12
  v_and_b32 v65, v58, v13
  v_and_b32 v66, v58, v14
  v_and_b32 v67, v58, v15
  v_mfma_f32_16x16x32_bf16 v[28:31], v[68:71], v[148:151], v[28:31]
  v_and_b32 v68, v59, v12
  v_and_b32 v69, v59, v13
PAD29:
  s_cbranch_execz PAD34
  v_and_b32 v70, v59, v14
  v_and_b32 v71, v59, v15
  v_mfma_f32_16x16x32_bf16 v[28:31], v[64:67], v[152:155], v[28:31]
  v_and_b32 v64, v60, v12
  v_and_b32 v65, v60, v13
  v_and_b32 v66, v60, v14
  v_and_b32 v67, v60, v15
  v_mfma_f32_16x16x32_bf16 v[28:31], v[68:71], v[156:159], v[28:31]
  v_and_b32 v68, v61, v12
  v_and_b32 v69, v61, v13
  v_and_b32 v70, v61, v14
  v_and_b32 v71, v61, v15
  v_mfma_f32_16x16x32_bf16 v[32:35], v[64:67], v[160:163], v[32:35]
PAD30:
  s_cbranch_execz PAD35
  s_nop 1
  v_mfma_f32_16x16x32_bf16 v[32:35], v[68:71], v[164:167], v[32:35]
  s_add_u32 s29, s29, 1
  s_and_b32 s34, s29, 15
  s_cbranch_scc1 L_loop
  s_cmpk_gt_u32 s29, 48
  s_cbranch_scc1 L_loop
  s_branch L_phase
L_final:
  s_mov_b32 s56, 1
L_phase:
  s_cmpk_lg_u32 s29, 16
  s_cbranch_scc1 L_nobar
  s_barrier
  v_and_b32 v8, 15, v0
PAD31:
  s_cbranch_execz PAD36
  v_lshrrev_b32 v9, 4, v0
  s_mul_i32 s38, s31, 1088
  s_lshl_b32 s66, s31, 2
  s_add_u32 s66, s66, 8704
  s_movk_i32 s61, 8960
  v_lshlrev_b32 v62, 5, v8
  v_lshl_add_u32 v62, v9, 4, v62
  v_add_u32 v62, s38, v62
  v_lshrrev_b32 v63, 3, v8
  v_lshlrev_b32 v63, 8, v63
  v_and_b32 v10, 7, v8
  v_lshl_add_u32 v63, v10, 5, v63
PAD32:
  s_cbranch_execz PAD37
  v_and_b32 v10, 1, v9
  v_lshl_add_u32 v63, v10, 4, v63
  v_add_u32 v63, s38, v63
  v_add_u32 v63, 512, v63
  s_lshl_b32 s34, s39, 1
  s_add_u32 s34, s34, s31
  s_lshl_b32 s34, s34, 8
  s_add_u32 s34, s34, 1048576
  s_add_u32 s52, s14, s34
  s_addc_u32 s53, s15, 0
  s_add_u32 s55, s36, 3
PAD33:
  s_cbranch_execz PAD38
  s_mul_i32 s55, s55, 1572864
  s_add_u32 s55, s55, 1179648
  s_mul_i32 s34, s31, 6144
  s_add_u32 s55, s55, s34
L_nobar:
  v_mov_b32 v8, v7
  s_nop 1
  v_permlane32_swap_b32 v7, v8
  v_add_f32 v7, v7, v8
  v_mov_b32 v8, v7
  s_nop 1
  v_permlane16_swap_b32 v7, v8
  v_add_f32 v53, v7, v8
PAD34:
  s_cbranch_execz PAD39
  v_mov_b32 v52, v5
  v_mov_b32 v8, s38
  v_mov_b32 v9, s66
  v_mov_b32 v10, 1
  s_mov_b32 exec_hi, 0
  ds_write_b128 v62, v[28:31]
  s_mov_b32 exec_lo, 0x00ff00ff
  s_mov_b32 exec_hi, 0xff00ff00
  ds_write_b128 v63, v[32:35]
  s_mov_b64 exec, 1
  ds_write_b64 v8, v[52:53] offset:1024
PAD35:
  s_cbranch_execz PAD40
  s_waitcnt lgkmcnt(0)
  ds_write_b32 v9, v10
  s_mov_b64 exec, -1
  s_cmp_lg_u32 s56, 0
  s_cbranch_scc1 L_sfin
  s_cmpk_eq_u32 s29, 48
  s_cselect_b32 s34, 2, 1
  v_lshlrev_b32 v9, 4, v0
  v_add_u32 v9, s61, v9
  v_mov_b32 v8, 8832
  s_mov_b32 s50, 4194304
L_qwait:
PAD36:
  s_cbranch_execz PAD41
  s_sub_u32 s50, s50, 1
  s_cbranch_scc1 L_qok
  ds_read_b32 v10, v8
  ds_read_b128 v[16:19], v9
  ds_read_b128 v[20:23], v9 offset:1024
  ds_read_b128 v[24:27], v9 offset:2048
  s_waitcnt lgkmcnt(0)
  v_cmp_gt_u32 vcc, s34, v10
  s_cbranch_vccnz L_qwait
L_qok:
  v_mov_b32 v5, 0xff7fffff
PAD37:
  s_cbranch_execz PAD42
  v_mov_b32 v6, 0xff7fffff
  v_mov_b32 v7, 0
  v_mov_b32 v28, 0
  v_mov_b32 v29, 0
  v_mov_b32 v30, 0
  v_mov_b32 v31, 0
  v_mov_b32 v32, 0
  v_mov_b32 v33, 0
  v_mov_b32 v34, 0
  v_mov_b32 v35, 0
  s_add_u32 s38, s38, 2176
  s_add_u32 s66, s66, 8
  s_add_u32 s61, s61, 3072
PAD38:
  s_cbranch_execz PAD43
  v_add_u32 v62, 2176, v62
  v_add_u32 v63, 2176, v63
  s_branch L_loop
L_dyn_m0:
  s_waitcnt lgkmcnt(0)
  s_cmpk_lt_u32 s54, 32
  s_cselect_b32 s65, 1, 0
  s_cselect_b32 s18, s60, 0
  s_cselect_b32 s22, s60, 0
  s_mul_i32 s28, s54, 12288
  s_add_u32 s28, s28, s55
  s_branch L_issue_m0
L_claim_m0:
PAD39:
  s_cbranch_execz PAD44
  s_cmp_eq_u32 s65, 0
  s_cbranch_scc1 L_claimed_m0
  s_mov_b32 s54, 1
  s_atomic_add s54, s[52:53], 0 glc
  s_branch L_claimed_m0
L_dyn_m1:
  s_waitcnt lgkmcnt(0)
  s_cmpk_lt_u32 s54, 32
  s_cselect_b32 s64, 1, 0
  s_cselect_b32 s18, s60, 0
  s_cselect_b32 s22, s60, 0
  s_mul_i32 s28, s54, 12288
  s_add_u32 s28, s28, s55
  s_branch L_issue_m1
L_claim_m1:
PAD40:
  s_cbranch_execz PAD45
  s_cmp_eq_u32 s64, 0
  s_cbranch_scc1 L_claimed_m1
  s_mov_b32 s54, 1
  s_atomic_add s54, s[52:53], 0 glc
  s_branch L_claimed_m1
L_sfin:
  s_endpgm
L_service:
  s_lshr_b32 s39, s2, 3
  s_and_b32 s37, s2, 7
  s_lshl_b32 s36, s39, 2
  s_waitcnt vmcnt(0)
  v_lshlrev_b32 v9, 2, v0
  v_mov_b32 v10, 0
  ds_write_b32 v9, v10 offset:8704
PAD41:
  s_cbranch_execz PAD46
  s_mov_b32 s30, 0x3dd53b95
  v_lshlrev_b32 v8, 4, v0
  v_lshrrev_b32 v9, 4, v0
  v_and_b32 v11, 3, v0
  v_lshlrev_b32 v10, 4, v11
  v_lshl_add_u32 v52, v9, 6, v10
  v_and_b32 v54, 1, v9
  v_lshl_add_u32 v54, v54, 6, v10
  v_add_u32 v54, 256, v54
  v_mov_b32 v10, 0x40000000
  v_cmp_gt_u32 vcc, 32, v0
PAD42:
  s_cbranch_execz PAD47
  s_nop 1
  v_cndmask_b32 v53, v10, v54, vcc
  v_cndmask_b32 v54, v54, v10, vcc
  s_waitcnt lgkmcnt(0)
  s_mul_i32 s34, s36, 384
  s_add_u32 s24, s4, s34
  s_addc_u32 s25, s5, 0
  s_and_b32 s25, s25, 0xffff
  s_mov_b32 s26, 1536
  s_mov_b32 s27, 0x20000
  s_movk_i32 s34, 384
PAD43:
  s_cbranch_execz PAD48
  buffer_load_dwordx4 v[72:75], v52, s[24:27], s34 offen
  buffer_load_dwordx4 v[76:79], v53, s[24:27], s34 offen
  buffer_load_dwordx4 v[80:83], v54, s[24:27], s34 offen
  s_movk_i32 s34, 768
  buffer_load_dwordx4 v[84:87], v52, s[24:27], s34 offen
  buffer_load_dwordx4 v[88:91], v53, s[24:27], s34 offen
  buffer_load_dwordx4 v[92:95], v54, s[24:27], s34 offen
  s_movk_i32 s34, 1152
  buffer_load_dwordx4 v[96:99], v52, s[24:27], s34 offen
PAD44:
  s_cbranch_execz PAD49
  buffer_load_dwordx4 v[100:103], v53, s[24:27], s34 offen
  buffer_load_dwordx4 v[104:107], v54, s[24:27], s34 offen
  s_mul_i32 s34, s36, 8192
  s_add_u32 s34, s34, 2097152
  s_add_u32 s58, s14, s34
  s_addc_u32 s59, s15, 0
  s_bitcmp1_b32 s37, 0
  s_cbranch_scc1 L_noclear
  s_lshr_b32 s34, s37, 1
  s_mul_i32 s62, s34, 8192
PAD45:
  s_cbranch_execz PAD50
  s_add_u32 s62, s58, s62
  s_addc_u32 s63, s59, 0
  v_mov_b32 v16, -1
  v_mov_b32 v17, -1
  v_mov_b32 v18, -1
  v_mov_b32 v19, -1
  v_mov_b32 v9, v8
  global_store_dwordx4 v9, v[16:19], s[62:63] sc1
  v_add_u32 v9, 1024, v9
  global_store_dwordx4 v9, v[16:19], s[62:63] sc1
  v_add_u32 v9, 1024, v9
PAD46:
  s_cbranch_execz PAD51
  global_store_dwordx4 v9, v[16:19], s[62:63] sc1
  v_add_u32 v9, 1024, v9
  global_store_dwordx4 v9, v[16:19], s[62:63] sc1
  v_add_u32 v9, 1024, v9
  global_store_dwordx4 v9, v[16:19], s[62:63] sc1
  v_add_u32 v9, 1024, v9
  global_store_dwordx4 v9, v[16:19], s[62:63] sc1
PAD47:
  s_cbranch_execz PAD52
  v_add_u32 v9, 1024, v9
  global_store_dwordx4 v9, v[16:19], s[62:63] sc1
  v_add_u32 v9, 1024, v9
  global_store_dwordx4 v9, v[16:19], s[62:63] sc1
  s_cmp_lg_u32 s37, 0
  s_cbranch_scc1 L_noctr
  s_mul_i32 s62, s39, 512
  s_add_u32 s62, s62, 1048576
  v_lshlrev_b32 v9, 8, v0
PAD48:
  s_cbranch_execz PAD53
  v_add_u32 v9, s62, v9
  v_mov_b32 v10, 0
  s_mov_b64 exec, 3
  global_store_dword v9, v10, s[14:15] sc1
  s_mov_b64 exec, -1
L_noctr:
  s_add_u32 s34, s34, s36
  v_mov_b32 v9, s34
  v_mov_b32 v10, 1
  s_waitcnt vmcnt(0)
  s_mov_b64 exec, 1
  global_store_byte v9, v10, s[12:13] offset:128 sc1
  s_mov_b64 exec, -1
L_noclear:
  s_waitcnt vmcnt(0)
PAD49:
  s_cbranch_execz PAD54
  ds_write_b128 v8, v[72:75] offset:8960
  ds_write_b128 v8, v[76:79] offset:9984
  ds_write_b128 v8, v[80:83] offset:11008
  ds_write_b128 v8, v[84:87] offset:12032
  ds_write_b128 v8, v[88:91] offset:13056
  ds_write_b128 v8, v[92:95] offset:14080
  ds_write_b128 v8, v[96:99] offset:15104
  ds_write_b128 v8, v[100:103] offset:16128
PAD50:
  s_cbranch_execz PAD55
  ds_write_b128 v8, v[104:107] offset:17152
  v_mov_b32 v9, 8832
  v_mov_b32 v10, 1
  ds_write_b32 v9, v10
  s_mov_b32 s51, 0
  s_mov_b32 s29, 0
  s_mov_b32 s38, 0
  s_waitcnt lgkmcnt(0)
  s_barrier
L_sphase:
  s_lshl_b32 s34, s29, 3
  s_add_u32 s34, s34, 8704
PAD51:
  s_cbranch_execz PAD56
  v_and_b32 v9, 1, v0
  v_lshl_add_u32 v9, v9, 2, s34
  s_mov_b32 s50, 4194304
L_swait:
  s_sub_u32 s50, s50, 1
  s_cbranch_scc1 L_sgo
  ds_read_b32 v10, v9
  s_waitcnt lgkmcnt(0)
  v_cmp_eq_u32 vcc, 0, v10
  s_cbranch_vccz L_sgo
  s_cmp_eq_u32 s29, 3
  s_cbranch_scc1 L_swait
PAD52:
  s_cbranch_execz PAD57
  s_sleep 8
  s_branch L_swait
L_sgo:
  v_add_u32 v9, s38, v8
  v_mov_b32 v10, s38
  ds_read_b128 v[72:75], v9 offset:0
  ds_read_b128 v[76:79], v9 offset:256
  ds_read_b64 v[80:81], v10 offset:1024
  ds_read_b128 v[84:87], v9 offset:1088
  ds_read_b128 v[88:91], v9 offset:1344
  ds_read_b64 v[92:93], v10 offset:2112
PAD53:
  s_cbranch_execz PAD58
  v_cmp_le_u32 vcc, 32, v0
  s_add_u32 s38, s38, 2176
  v_mov_b32 v28, v24
  v_mov_b32 v29, v25
  v_mov_b32 v30, v26
  v_mov_b32 v31, v27
  v_mov_b32 v24, v20
  v_mov_b32 v25, v21
  v_mov_b32 v26, v22
  v_mov_b32 v27, v23
  v_mov_b32 v20, v16
  v_mov_b32 v21, v17
  v_mov_b32 v22, v18
PAD54:
  s_cbranch_execz PAD59
  v_mov_b32 v23, v19
  s_waitcnt lgkmcnt(0)
  v_max_f32 v5, v80, v92
  v_mul_f32 v6, s30, v5
  v_fma_f32 v10, v80, s30, -v6
  v_fma_f32 v11, v92, s30, -v6
  v_exp_f32 v10, v10
  v_exp_f32 v11, v11
  v_cndmask_b32 v76, 0, v76, vcc
  v_cndmask_b32 v77, 0, v77, vcc
  v_cndmask_b32 v78, 0, v78, vcc
  v_cndmask_b32 v79, 0, v79, vcc
  v_add_f32 v72, v72, v76
PAD55:
  s_cbranch_execz PAD60
  v_add_f32 v73, v73, v77
  v_add_f32 v74, v74, v78
  v_add_f32 v75, v75, v79
  v_cndmask_b32 v88, 0, v88, vcc
  v_cndmask_b32 v89, 0, v89, vcc
  v_cndmask_b32 v90, 0, v90, vcc
  v_cndmask_b32 v91, 0, v91, vcc
  v_add_f32 v84, v84, v88
  v_add_f32 v85, v85, v89
  v_add_f32 v86, v86, v90
  v_add_f32 v87, v87, v91
  v_mul_f32 v7, v10, v81
  v_fma_f32 v7, v11, v93, v7
  v_mul_f32 v16, v10, v72
PAD56:
  s_cbranch_execz PAD61
  v_mul_f32 v17, v10, v73
  v_mul_f32 v18, v10, v74
  v_mul_f32 v19, v10, v75
  v_fma_f32 v16, v11, v84, v16
  v_fma_f32 v17, v11, v85, v17
  v_fma_f32 v18, v11, v86, v18
  v_fma_f32 v19, v11, v87, v19
  s_mov_b32 exec_lo, 0
  s_mov_b32 exec_hi, 0x10000
  v_mov_b32 v16, v5
PAD57:
  s_cbranch_execz PAD62
  v_mov_b32 v17, v7
  v_mov_b32 v18, v5
  v_mov_b32 v19, v7
  s_mov_b64 exec, -1
  s_add_u32 s29, s29, 1
  s_cmp_ge_u32 s29, 4
  s_cbranch_scc1 L_pub
  s_cmp_lg_u32 s51, 0
  s_cbranch_scc1 L_sphase
  v_and_b32 v9, 3, v0
  v_add_u32 v9, s36, v9
  s_mov_b32 s50, 4194304
L_rdy:
  s_sub_u32 s50, s50, 1
  s_cbranch_scc1 L_rdy_set
PAD58:
  s_cbranch_execz PAD63
  global_load_ubyte v10, v9, s[12:13] offset:128 sc1
  s_waitcnt vmcnt(0)
  v_cmp_eq_u32 vcc, 0, v10
  s_cbranch_vccz L_rdy_set
  s_sleep 8
  s_branch L_rdy
L_rdy_set:
  s_mov_b32 s51, 1
  v_mov_b32 v9, 8832
  v_mov_b32 v10, 2
  ds_write_b32 v9, v10
  s_branch L_sphase
L_pub:
  s_lshl_b32 s34, s37, 10
PAD59:
  s_cbranch_execz PAD64
  v_add_u32 v9, s34, v8
  s_add_u32 s62, s58, 24576
  s_addc_u32 s63, s59, 0
  s_mov_b32 exec_hi, 0x1ffff
  global_store_dwordx4 v9, v[16:19], s[62:63] sc1
  s_sub_u32 s62, s62, 8192
  s_subb_u32 s63, s63, 0
  global_store_dwordx4 v9, v[20:23], s[62:63] sc1
  s_sub_u32 s62, s62, 8192
PAD60:
  s_cbranch_execz PAD65
  s_subb_u32 s63, s63, 0
  global_store_dwordx4 v9, v[24:27], s[62:63] sc1
  s_sub_u32 s62, s62, 8192
  s_subb_u32 s63, s63, 0
  global_store_dwordx4 v9, v[28:31], s[62:63] sc1
  s_mov_b64 exec, -1
  s_bitcmp1_b32 s37, 0
  s_cbranch_scc1 L_sdone
  s_lshr_b32 s29, s37, 1
  s_mul_i32 s34, s29, 8192
  s_add_u32 s66, s58, s34
PAD61:
  s_cbranch_execz PAD66
  s_addc_u32 s67, s59, 0
  s_add_u32 s62, s66, 4096
  s_addc_u32 s63, s67, 0
  v_and_b32 v9, 7, v0
  v_lshlrev_b32 v9, 10, v9
  v_min_u32 v10, 768, v8
  s_mov_b32 s50, 4194304
L_poll:
  s_sub_u32 s50, s50, 1
  s_cbranch_scc1 L_sdone
  global_load_dwordx2 v[52:53], v9, s[66:67] offset:768 sc1
  global_load_dwordx4 v[72:75], v10, s[66:67] offset:0 sc1
PAD62:
  s_cbranch_execz PAD67
  global_load_dwordx4 v[76:79], v10, s[66:67] offset:1024 sc1
  global_load_dwordx4 v[80:83], v10, s[66:67] offset:2048 sc1
  global_load_dwordx4 v[84:87], v10, s[66:67] offset:3072 sc1
  global_load_dwordx4 v[88:91], v10, s[62:63] offset:0 sc1
  global_load_dwordx4 v[92:95], v10, s[62:63] offset:1024 sc1
  global_load_dwordx4 v[96:99], v10, s[62:63] offset:2048 sc1
  global_load_dwordx4 v[100:103], v10, s[62:63] offset:3072 sc1
PAD63:
  s_cbranch_execz PAD68
  s_waitcnt vmcnt(0)
  v_max_u32 v7, v52, v53
  v_max3_u32 v7, v72, v73, v7
  v_max3_u32 v7, v74, v75, v7
  v_max3_u32 v7, v76, v77, v7
  v_max3_u32 v7, v78, v79, v7
  v_max3_u32 v7, v80, v81, v7
  v_max3_u32 v7, v82, v83, v7
  v_max3_u32 v7, v84, v85, v7
PAD64:
  s_cbranch_execz PAD69
  v_max3_u32 v7, v86, v87, v7
  v_max3_u32 v7, v88, v89, v7
  v_max3_u32 v7, v90, v91, v7
  v_max3_u32 v7, v92, v93, v7
  v_max3_u32 v7, v94, v95, v7
  v_max3_u32 v7, v96, v97, v7
  v_max3_u32 v7, v98, v99, v7
PAD65:
  s_cbranch_execz PAD70
  v_max3_u32 v7, v100, v101, v7
  v_max3_u32 v7, v102, v103, v7
  v_cmp_eq_u32 vcc, -1, v7
  s_cbranch_vccnz L_poll
  v_mov_b32 v5, v52
  s_nop 1
  v_max_f32_dpp v5, v5, v5 row_ror:4 row_mask:0xf bank_mask:0xf
  s_nop 1
  v_max_f32_dpp v5, v5, v5 row_ror:2 row_mask:0xf bank_mask:0xf
  s_nop 1
  v_max_f32_dpp v5, v5, v5 row_ror:1 row_mask:0xf bank_mask:0xf
PAD66:
  s_cbranch_execz PAD71
  s_nop 1
  v_mul_f32 v6, s30, v5
  v_fma_f32 v56, v52, s30, -v6
  v_exp_f32 v56, v56
  s_nop 0
  v_mul_f32 v7, v56, v53
  s_nop 1
  v_add_f32_dpp v7, v7, v7 row_ror:4 row_mask:0xf bank_mask:0xf
  s_nop 1
  v_add_f32_dpp v7, v7, v7 row_ror:2 row_mask:0xf bank_mask:0xf
  s_nop 1
PAD67:
  s_cbranch_execz PAD72
  v_add_f32_dpp v7, v7, v7 row_ror:1 row_mask:0xf bank_mask:0xf
  s_nop 1
  v_rcp_f32 v7, v7
  s_nop 0
  v_mul_f32 v56, v56, v7
  s_nop 0
  v_readlane_b32 s68, v56, 0
  v_readlane_b32 s69, v56, 1
  v_readlane_b32 s70, v56, 2
  v_readlane_b32 s71, v56, 3
PAD68:
  s_cbranch_execz PAD73
  v_readlane_b32 s72, v56, 4
  v_readlane_b32 s73, v56, 5
  v_readlane_b32 s74, v56, 6
  v_readlane_b32 s75, v56, 7
  s_nop 1
  v_mul_f32 v40, s68, v72
  v_mul_f32 v41, s68, v73
  v_mul_f32 v42, s68, v74
  v_mul_f32 v43, s68, v75
  v_fma_f32 v40, s69, v76, v40
PAD69:
  s_cbranch_execz L_hend
  v_fma_f32 v41, s69, v77, v41
  v_fma_f32 v42, s69, v78, v42
  v_fma_f32 v43, s69, v79, v43
  v_fma_f32 v40, s70, v80, v40
  v_fma_f32 v41, s70, v81, v41
  v_fma_f32 v42, s70, v82, v42
  v_fma_f32 v43, s70, v83, v43
  v_fma_f32 v40, s71, v84, v40
PAD70:
  s_cbranch_execz L_hend
  v_fma_f32 v41, s71, v85, v41
  v_fma_f32 v42, s71, v86, v42
  v_fma_f32 v43, s71, v87, v43
  v_fma_f32 v40, s72, v88, v40
  v_fma_f32 v41, s72, v89, v41
  v_fma_f32 v42, s72, v90, v42
  v_fma_f32 v43, s72, v91, v43
PAD71:
  s_cbranch_execz L_hend
  v_fma_f32 v40, s73, v92, v40
  v_fma_f32 v41, s73, v93, v41
  v_fma_f32 v42, s73, v94, v42
  v_fma_f32 v43, s73, v95, v43
  v_fma_f32 v40, s74, v96, v40
  v_fma_f32 v41, s74, v97, v41
  v_fma_f32 v42, s74, v98, v42
  v_fma_f32 v43, s74, v99, v43
PAD72:
  s_cbranch_execz L_hend
  v_fma_f32 v40, s75, v100, v40
  v_fma_f32 v41, s75, v101, v41
  v_fma_f32 v42, s75, v102, v42
  v_fma_f32 v43, s75, v103, v43
  v_cvt_pk_bf16_f32 v52, v40, v41
  v_cvt_pk_bf16_f32 v53, v42, v43
  s_add_u32 s34, s36, s29
  s_mul_i32 s34, s34, 384
PAD73:
  s_cbranch_execz L_hend
  v_lshlrev_b32 v9, 3, v0
  v_add_u32 v9, s34, v9
  s_mov_b32 exec_hi, 0xffff
  global_store_dwordx2 v9, v[52:53], s[10:11]
L_sdone:
L_end:
  s_endpgm
L_hend:
  s_barrier
  s_endpgm
.section .rodata,"a"
.p2align 6
.amdhsa_kernel standalone__softmax_full_bidir__decode_kernel
  .amdhsa_next_free_vgpr 168
  .amdhsa_next_free_sgpr 100
  .amdhsa_accum_offset 168
  .amdhsa_group_segment_fixed_size 0
  .amdhsa_kernarg_size 48
  .amdhsa_user_sgpr_count 2
  .amdhsa_user_sgpr_kernarg_segment_ptr 1
  .amdhsa_system_sgpr_workgroup_id_x 1
.end_amdhsa_kernel
```
